```python
import torch

def _softmax(x, axis=-1):
    return torch.softmax(x, dim=axis)
def _gelu(x):
    return torch.nn.functional.gelu(x, approximate="tanh")
def _silu(x):
    return torch.nn.functional.silu(x)
def _sigmoid(x):
    return torch.sigmoid(x)
def _layernorm(x, axis=-1, eps=1e-5):
    m = x.mean(dim=axis, keepdim=True)
    v = x.var(dim=axis, keepdim=True, unbiased=False)
    return (x - m) / torch.sqrt(v + eps)
def _scatter_add(tgt, idx, src, axis=0):
    return tgt.clone().index_add_(axis, idx, src)
def _segment_sum(src, seg, n):
    out = torch.zeros((n,) + src.shape[1:], dtype=src.dtype)
    return out.index_add_(0, seg, src)
def _pad(x, pw):
    flat = tuple(v for pair in reversed(pw) for v in pair)
    return torch.nn.functional.pad(x, flat)

kernel_name = 'standalone__sliding_block_cached__decode'

def setup_inputs():

    _w = (lambda a: (lambda t: t.to(torch.bfloat16) if t.is_floating_point() else t)(torch.as_tensor(a)))
    B, Sq, D = 2, 1, 640
    Hq, Hkv, Sk, Dh = 32, 32, 4096, 128
    assert Hq % Hkv == 0, (Hq, Hkv)
    return {
        "x": _w((lambda *s: torch.randn(*s, dtype=torch.bfloat16) * 0.8)(B, Sq, D)),
        "k_cache": _w((lambda *s: torch.randn(*s, dtype=torch.bfloat16) * 0.8)(B, Hkv, Sk, Dh)),
        "v_cache": _w((lambda *s: torch.randn(*s, dtype=torch.bfloat16) * 0.05)(B, Hkv, Sk, Dh)),
        "wq": _w((lambda *s: torch.randn(*s, dtype=torch.bfloat16) * 0.8)(D, Hq * Dh) * (D ** -0.5)),
        "wo": _w((lambda *s: torch.randn(*s, dtype=torch.bfloat16) * 0.05)(Hq * Dh, D) * ((Hq * Dh) ** -0.5)),
    }

def reference(x, k_cache, v_cache, wq, wo):
    B, Sq, D = x.shape
    Hq, Dh = 32, 128
    Hkv, Sk = k_cache.shape[1], k_cache.shape[2]
    W = min(4096, max(256, Sk // 4))
    rep = Hq // Hkv
    q = (lambda x, *d: x.permute(*d))((x @ wq).reshape(B, Sq, Hq, Dh), 0, 2, 1, 3)
    k = (lambda x, n, axis: torch.repeat_interleave(x, n, dim=axis))(k_cache[:, :, Sk - W:, :], rep, axis=1)
    v = (lambda x, n, axis: torch.repeat_interleave(x, n, dim=axis))(v_cache[:, :, Sk - W:, :], rep, axis=1)
    scores = torch.einsum("bhqd,bhkd->bhqk", q, k) * (Dh ** -0.5)
    p = _softmax(scores, axis=-1)
    o = torch.einsum("bhqk,bhkd->bhqd", p, v)
    return (lambda x, *d: x.permute(*d))(o, 0, 2, 1, 3).reshape(B, Sq, Hq * Dh) @ wo
```

```asm
; @launch kernel=standalone__sliding_block_cached__decode_kernel grid=(256,1,1) block=(384,1,1) lds=4096
; @launch kernel=final_reduce_kernel grid=(40,1,1) block=(256,1,1) lds=4096
.amdgcn_target "amdgcn-amd-amdhsa--gfx950"
.text
.globl standalone__sliding_block_cached__decode_kernel
.globl final_reduce_kernel
.p2align 8
.type standalone__sliding_block_cached__decode_kernel,@function
standalone__sliding_block_cached__decode_kernel:
s_cmp_ge_u32 s2, 256
s_cbranch_scc1 L_k1_end
s_load_dwordx16 s[4:19], s[0:1], 0
s_memrealtime s[96:97]
v_lshrrev_b32 v9, 6, v0
v_and_b32 v1, 63, v0
v_readfirstlane_b32 s46, v9
v_and_b32 v2, 15, v1
v_lshrrev_b32 v3, 4, v1
s_and_b32 s44, s2, 7
s_lshl_b32 s44, s44, 2
s_bfe_u32 s55, s2, 0x20003
s_or_b32 s44, s44, s55
s_lshr_b32 s45, s2, 5
v_mov_b32 v31, 0
s_cmp_eq_u32 s46, 0
s_cbranch_scc1 L_k1_hq
s_cmp_eq_u32 s46, 1
s_cbranch_scc1 L_k1_ho
s_sub_u32 s48, s46, 2
v_lshlrev_b32 v6, 8, v2
v_lshl_add_u32 v6, v3, 4, v6
v_lshlrev_b32 v7, 10, v3
v_lshl_add_u32 v7, v2, 4, v7
s_lshr_b32 s47, s48, 1
s_lshl_b32 s49, s47, 5
s_add_u32 s49, s49, s44
s_lshl_b32 s49, s49, 20
s_add_u32 s49, s49, 786432
s_lshl_b32 s55, s45, 15
s_add_u32 s49, s49, s55
s_and_b32 s55, s48, 1
s_lshl_b32 s55, s55, 14
s_add_u32 s49, s49, s55
s_add_u32 s50, s49, 4096
s_add_u32 s51, s49, 8192
s_add_u32 s52, s49, 12288
s_mov_b32 s58, 0x3e0293ee
s_mov_b32 s79, 0
s_lshl_b32 s55, s47, 8
v_lshl_add_u32 v8, v2, 4, s55
v_mov_b32 v9, 2624
s_lshl_b32 s55, s48, 9
v_lshlrev_b32 v10, 5, v2
v_lshl_add_u32 v10, v3, 4, v10
v_add_u32 v10, s55, v10
s_lshl_b32 s55, s48, 3
v_mov_b32 v11, s55
v_and_b32 v28, 1, v2
v_lshlrev_b32 v28, 4, v28
v_mov_b32 v29, 0xffff
v_lshlrev_b32 v28, v28, v29
v_bfe_u32 v29, v2, 1, 2
v_cmp_eq_u32 vcc, 0, v29
s_nop 1
v_cndmask_b32 v20, 0, v28, vcc
v_cmp_eq_u32 vcc, 1, v29
s_nop 1
v_cndmask_b32 v21, 0, v28, vcc
v_cmp_eq_u32 vcc, 2, v29
s_nop 1
v_cndmask_b32 v22, 0, v28, vcc
v_cmp_eq_u32 vcc, 3, v29
s_nop 1
v_cndmask_b32 v23, 0, v28, vcc
s_waitcnt lgkmcnt(0)
s_mov_b32 s24, s6
s_mov_b32 s25, s7
s_mov_b32 s26, 67108864
s_mov_b32 s27, 0x00020000
s_mov_b32 s28, s8
s_mov_b32 s29, s9
s_mov_b32 s30, 67108864
s_mov_b32 s31, 0x00020000
buffer_load_dwordx4 v[64:67], v7, s[24:27], s49 offen offset:0 nt
buffer_load_dwordx4 v[68:71], v7, s[24:27], s49 offen offset:256 nt
s_barrier
buffer_load_dwordx4 v[72:75], v7, s[24:27], s49 offen offset:512 nt
buffer_load_dwordx4 v[76:79], v7, s[24:27], s49 offen offset:768 nt
buffer_load_dwordx4 v[80:83], v7, s[24:27], s50 offen offset:0 nt
buffer_load_dwordx4 v[84:87], v7, s[24:27], s50 offen offset:256 nt
buffer_load_dwordx4 v[88:91], v7, s[24:27], s50 offen offset:512 nt
buffer_load_dwordx4 v[92:95], v7, s[24:27], s50 offen offset:768 nt
s_waitcnt vmcnt(7)
buffer_load_dwordx4 v[96:99], v7, s[24:27], s51 offen offset:0 nt
s_waitcnt vmcnt(7)
buffer_load_dwordx4 v[100:103], v7, s[24:27], s51 offen offset:256 nt
s_waitcnt vmcnt(7)
buffer_load_dwordx4 v[104:107], v7, s[24:27], s51 offen offset:512 nt
s_waitcnt vmcnt(7)
buffer_load_dwordx4 v[108:111], v7, s[24:27], s51 offen offset:768 nt
s_waitcnt vmcnt(7)
buffer_load_dwordx4 v[112:115], v7, s[24:27], s52 offen offset:0 nt
s_waitcnt vmcnt(7)
buffer_load_dwordx4 v[116:119], v7, s[24:27], s52 offen offset:256 nt
s_waitcnt vmcnt(7)
buffer_load_dwordx4 v[120:123], v7, s[24:27], s52 offen offset:512 nt
s_waitcnt vmcnt(7)
buffer_load_dwordx4 v[124:127], v7, s[24:27], s52 offen offset:768 nt
ds_read_b32 v28, v9
s_waitcnt lgkmcnt(0)
v_readfirstlane_b32 s59, v28
s_nop 3
s_cmp_lg_u32 s59, 0
s_cbranch_scc1 L_k1_rest0
s_waitcnt vmcnt(7)
buffer_load_dwordx4 v[128:131], v7, s[28:31], s49 offen offset:0 nt
s_waitcnt vmcnt(7)
buffer_load_dwordx4 v[132:135], v7, s[28:31], s49 offen offset:256 nt
ds_read_b32 v28, v9
s_waitcnt lgkmcnt(0)
v_readfirstlane_b32 s59, v28
s_nop 3
s_cmp_lg_u32 s59, 0
s_cbranch_scc1 L_k1_rest2
s_waitcnt vmcnt(7)
buffer_load_dwordx4 v[136:139], v7, s[28:31], s49 offen offset:512 nt
s_waitcnt vmcnt(7)
buffer_load_dwordx4 v[140:143], v7, s[28:31], s49 offen offset:768 nt
ds_read_b32 v28, v9
s_waitcnt lgkmcnt(0)
v_readfirstlane_b32 s59, v28
s_nop 3
s_cmp_lg_u32 s59, 0
s_cbranch_scc1 L_k1_rest4
s_waitcnt vmcnt(7)
buffer_load_dwordx4 v[144:147], v7, s[28:31], s50 offen offset:0 nt
s_waitcnt vmcnt(7)
buffer_load_dwordx4 v[148:151], v7, s[28:31], s50 offen offset:256 nt
ds_read_b32 v28, v9
s_waitcnt lgkmcnt(0)
v_readfirstlane_b32 s59, v28
s_nop 3
s_cmp_lg_u32 s59, 0
s_cbranch_scc1 L_k1_rest6
s_waitcnt vmcnt(7)
buffer_load_dwordx4 v[152:155], v7, s[28:31], s50 offen offset:512 nt
s_waitcnt vmcnt(7)
buffer_load_dwordx4 v[156:159], v7, s[28:31], s50 offen offset:768 nt
ds_read_b32 v28, v9
s_waitcnt lgkmcnt(0)
v_readfirstlane_b32 s59, v28
s_nop 3
s_cmp_lg_u32 s59, 0
s_cbranch_scc1 L_k1_rest8
s_waitcnt vmcnt(7)
buffer_load_dwordx4 v[160:163], v7, s[28:31], s51 offen offset:0 nt
s_waitcnt vmcnt(7)
buffer_load_dwordx4 v[164:167], v7, s[28:31], s51 offen offset:256 nt
ds_read_b32 v28, v9
s_waitcnt lgkmcnt(0)
v_readfirstlane_b32 s59, v28
s_nop 3
s_cmp_lg_u32 s59, 0
s_cbranch_scc1 L_k1_rest10
s_waitcnt vmcnt(7)
buffer_load_dwordx4 v[168:171], v7, s[28:31], s51 offen offset:512 nt
s_waitcnt vmcnt(7)
buffer_load_dwordx4 v[172:175], v7, s[28:31], s51 offen offset:768 nt
ds_read_b32 v28, v9
s_waitcnt lgkmcnt(0)
v_readfirstlane_b32 s59, v28
s_nop 3
s_cmp_lg_u32 s59, 0
s_cbranch_scc1 L_k1_rest12
s_waitcnt vmcnt(7)
buffer_load_dwordx4 v[176:179], v7, s[28:31], s52 offen offset:0 nt
s_waitcnt vmcnt(7)
buffer_load_dwordx4 v[180:183], v7, s[28:31], s52 offen offset:256 nt
ds_read_b32 v28, v9
s_waitcnt lgkmcnt(0)
v_readfirstlane_b32 s59, v28
s_nop 3
s_cmp_lg_u32 s59, 0
s_cbranch_scc1 L_k1_rest14
s_waitcnt vmcnt(7)
buffer_load_dwordx4 v[184:187], v7, s[28:31], s52 offen offset:512 nt
s_waitcnt vmcnt(7)
buffer_load_dwordx4 v[188:191], v7, s[28:31], s52 offen offset:768 nt
L_k1_qspin:
ds_read_b32 v28, v9
s_waitcnt lgkmcnt(0)
v_readfirstlane_b32 s59, v28
s_nop 3
s_cmp_eq_u32 s59, 0
s_cbranch_scc1 L_k1_qspin
s_branch L_k1_qk
L_k1_rest0:
buffer_load_dwordx4 v[128:131], v7, s[28:31], s49 offen offset:0 nt
buffer_load_dwordx4 v[132:135], v7, s[28:31], s49 offen offset:256 nt
L_k1_rest2:
buffer_load_dwordx4 v[136:139], v7, s[28:31], s49 offen offset:512 nt
buffer_load_dwordx4 v[140:143], v7, s[28:31], s49 offen offset:768 nt
L_k1_rest4:
buffer_load_dwordx4 v[144:147], v7, s[28:31], s50 offen offset:0 nt
buffer_load_dwordx4 v[148:151], v7, s[28:31], s50 offen offset:256 nt
L_k1_rest6:
buffer_load_dwordx4 v[152:155], v7, s[28:31], s50 offen offset:512 nt
buffer_load_dwordx4 v[156:159], v7, s[28:31], s50 offen offset:768 nt
L_k1_rest8:
buffer_load_dwordx4 v[160:163], v7, s[28:31], s51 offen offset:0 nt
buffer_load_dwordx4 v[164:167], v7, s[28:31], s51 offen offset:256 nt
L_k1_rest10:
buffer_load_dwordx4 v[168:171], v7, s[28:31], s51 offen offset:512 nt
buffer_load_dwordx4 v[172:175], v7, s[28:31], s51 offen offset:768 nt
L_k1_rest12:
buffer_load_dwordx4 v[176:179], v7, s[28:31], s52 offen offset:0 nt
buffer_load_dwordx4 v[180:183], v7, s[28:31], s52 offen offset:256 nt
L_k1_rest14:
buffer_load_dwordx4 v[184:187], v7, s[28:31], s52 offen offset:512 nt
buffer_load_dwordx4 v[188:191], v7, s[28:31], s52 offen offset:768 nt
L_k1_qk:
ds_read_b128 v[44:47], v8 offset:0
s_waitcnt vmcnt(16) lgkmcnt(0)
v_dot2_f32_bf16 v192, v64, v44, 0
v_dot2_f32_bf16 v193, v68, v44, 0
v_dot2_f32_bf16 v194, v72, v44, 0
v_dot2_f32_bf16 v195, v76, v44, 0
v_dot2_f32_bf16 v196, v80, v44, 0
v_dot2_f32_bf16 v197, v84, v44, 0
v_dot2_f32_bf16 v198, v88, v44, 0
v_dot2_f32_bf16 v199, v92, v44, 0
v_dot2_f32_bf16 v200, v96, v44, 0
v_dot2_f32_bf16 v201, v100, v44, 0
v_dot2_f32_bf16 v202, v104, v44, 0
v_dot2_f32_bf16 v203, v108, v44, 0
v_dot2_f32_bf16 v204, v112, v44, 0
v_dot2_f32_bf16 v205, v116, v44, 0
v_dot2_f32_bf16 v206, v120, v44, 0
v_dot2_f32_bf16 v207, v124, v44, 0
v_dot2_f32_bf16 v192, v65, v45, v192
v_dot2_f32_bf16 v193, v69, v45, v193
v_dot2_f32_bf16 v194, v73, v45, v194
v_dot2_f32_bf16 v195, v77, v45, v195
v_dot2_f32_bf16 v196, v81, v45, v196
v_dot2_f32_bf16 v197, v85, v45, v197
v_dot2_f32_bf16 v198, v89, v45, v198
v_dot2_f32_bf16 v199, v93, v45, v199
v_dot2_f32_bf16 v200, v97, v45, v200
v_dot2_f32_bf16 v201, v101, v45, v201
v_dot2_f32_bf16 v202, v105, v45, v202
v_dot2_f32_bf16 v203, v109, v45, v203
v_dot2_f32_bf16 v204, v113, v45, v204
v_dot2_f32_bf16 v205, v117, v45, v205
v_dot2_f32_bf16 v206, v121, v45, v206
v_dot2_f32_bf16 v207, v125, v45, v207
v_dot2_f32_bf16 v192, v66, v46, v192
v_dot2_f32_bf16 v193, v70, v46, v193
v_dot2_f32_bf16 v194, v74, v46, v194
v_dot2_f32_bf16 v195, v78, v46, v195
v_dot2_f32_bf16 v196, v82, v46, v196
v_dot2_f32_bf16 v197, v86, v46, v197
v_dot2_f32_bf16 v198, v90, v46, v198
v_dot2_f32_bf16 v199, v94, v46, v199
v_dot2_f32_bf16 v200, v98, v46, v200
v_dot2_f32_bf16 v201, v102, v46, v201
v_dot2_f32_bf16 v202, v106, v46, v202
v_dot2_f32_bf16 v203, v110, v46, v203
v_dot2_f32_bf16 v204, v114, v46, v204
v_dot2_f32_bf16 v205, v118, v46, v205
v_dot2_f32_bf16 v206, v122, v46, v206
v_dot2_f32_bf16 v207, v126, v46, v207
v_dot2_f32_bf16 v192, v67, v47, v192
v_dot2_f32_bf16 v193, v71, v47, v193
v_dot2_f32_bf16 v194, v75, v47, v194
v_dot2_f32_bf16 v195, v79, v47, v195
v_dot2_f32_bf16 v196, v83, v47, v196
v_dot2_f32_bf16 v197, v87, v47, v197
v_dot2_f32_bf16 v198, v91, v47, v198
v_dot2_f32_bf16 v199, v95, v47, v199
v_dot2_f32_bf16 v200, v99, v47, v200
v_dot2_f32_bf16 v201, v103, v47, v201
v_dot2_f32_bf16 v202, v107, v47, v202
v_dot2_f32_bf16 v203, v111, v47, v203
v_dot2_f32_bf16 v204, v115, v47, v204
v_dot2_f32_bf16 v205, v119, v47, v205
v_dot2_f32_bf16 v206, v123, v47, v206
v_dot2_f32_bf16 v207, v127, v47, v207
v_add_f32_dpp v192, v192, v192 row_ror:8 row_mask:0xf bank_mask:0xf
v_add_f32_dpp v193, v193, v193 row_ror:8 row_mask:0xf bank_mask:0xf
v_add_f32_dpp v194, v194, v194 row_ror:8 row_mask:0xf bank_mask:0xf
v_add_f32_dpp v195, v195, v195 row_ror:8 row_mask:0xf bank_mask:0xf
v_add_f32_dpp v196, v196, v196 row_ror:8 row_mask:0xf bank_mask:0xf
v_add_f32_dpp v197, v197, v197 row_ror:8 row_mask:0xf bank_mask:0xf
v_add_f32_dpp v198, v198, v198 row_ror:8 row_mask:0xf bank_mask:0xf
v_add_f32_dpp v199, v199, v199 row_ror:8 row_mask:0xf bank_mask:0xf
v_add_f32_dpp v200, v200, v200 row_ror:8 row_mask:0xf bank_mask:0xf
v_add_f32_dpp v201, v201, v201 row_ror:8 row_mask:0xf bank_mask:0xf
v_add_f32_dpp v202, v202, v202 row_ror:8 row_mask:0xf bank_mask:0xf
v_add_f32_dpp v203, v203, v203 row_ror:8 row_mask:0xf bank_mask:0xf
v_add_f32_dpp v204, v204, v204 row_ror:8 row_mask:0xf bank_mask:0xf
v_add_f32_dpp v205, v205, v205 row_ror:8 row_mask:0xf bank_mask:0xf
v_add_f32_dpp v206, v206, v206 row_ror:8 row_mask:0xf bank_mask:0xf
v_add_f32_dpp v207, v207, v207 row_ror:8 row_mask:0xf bank_mask:0xf
v_add_f32_dpp v192, v192, v192 row_ror:4 row_mask:0xf bank_mask:0xf
v_add_f32_dpp v193, v193, v193 row_ror:4 row_mask:0xf bank_mask:0xf
v_add_f32_dpp v194, v194, v194 row_ror:4 row_mask:0xf bank_mask:0xf
v_add_f32_dpp v195, v195, v195 row_ror:4 row_mask:0xf bank_mask:0xf
v_add_f32_dpp v196, v196, v196 row_ror:4 row_mask:0xf bank_mask:0xf
v_add_f32_dpp v197, v197, v197 row_ror:4 row_mask:0xf bank_mask:0xf
v_add_f32_dpp v198, v198, v198 row_ror:4 row_mask:0xf bank_mask:0xf
v_add_f32_dpp v199, v199, v199 row_ror:4 row_mask:0xf bank_mask:0xf
v_add_f32_dpp v200, v200, v200 row_ror:4 row_mask:0xf bank_mask:0xf
v_add_f32_dpp v201, v201, v201 row_ror:4 row_mask:0xf bank_mask:0xf
v_add_f32_dpp v202, v202, v202 row_ror:4 row_mask:0xf bank_mask:0xf
v_add_f32_dpp v203, v203, v203 row_ror:4 row_mask:0xf bank_mask:0xf
v_add_f32_dpp v204, v204, v204 row_ror:4 row_mask:0xf bank_mask:0xf
v_add_f32_dpp v205, v205, v205 row_ror:4 row_mask:0xf bank_mask:0xf
v_add_f32_dpp v206, v206, v206 row_ror:4 row_mask:0xf bank_mask:0xf
v_add_f32_dpp v207, v207, v207 row_ror:4 row_mask:0xf bank_mask:0xf
v_add_f32_dpp v192, v192, v192 row_ror:2 row_mask:0xf bank_mask:0xf
v_add_f32_dpp v193, v193, v193 row_ror:2 row_mask:0xf bank_mask:0xf
v_add_f32_dpp v194, v194, v194 row_ror:2 row_mask:0xf bank_mask:0xf
v_add_f32_dpp v195, v195, v195 row_ror:2 row_mask:0xf bank_mask:0xf
v_add_f32_dpp v196, v196, v196 row_ror:2 row_mask:0xf bank_mask:0xf
v_add_f32_dpp v197, v197, v197 row_ror:2 row_mask:0xf bank_mask:0xf
v_add_f32_dpp v198, v198, v198 row_ror:2 row_mask:0xf bank_mask:0xf
v_add_f32_dpp v199, v199, v199 row_ror:2 row_mask:0xf bank_mask:0xf
v_add_f32_dpp v200, v200, v200 row_ror:2 row_mask:0xf bank_mask:0xf
v_add_f32_dpp v201, v201, v201 row_ror:2 row_mask:0xf bank_mask:0xf
v_add_f32_dpp v202, v202, v202 row_ror:2 row_mask:0xf bank_mask:0xf
v_add_f32_dpp v203, v203, v203 row_ror:2 row_mask:0xf bank_mask:0xf
v_add_f32_dpp v204, v204, v204 row_ror:2 row_mask:0xf bank_mask:0xf
v_add_f32_dpp v205, v205, v205 row_ror:2 row_mask:0xf bank_mask:0xf
v_add_f32_dpp v206, v206, v206 row_ror:2 row_mask:0xf bank_mask:0xf
v_add_f32_dpp v207, v207, v207 row_ror:2 row_mask:0xf bank_mask:0xf
v_add_f32_dpp v192, v192, v192 row_ror:1 row_mask:0xf bank_mask:0xf
v_add_f32_dpp v193, v193, v193 row_ror:1 row_mask:0xf bank_mask:0xf
v_add_f32_dpp v194, v194, v194 row_ror:1 row_mask:0xf bank_mask:0xf
v_add_f32_dpp v195, v195, v195 row_ror:1 row_mask:0xf bank_mask:0xf
v_add_f32_dpp v196, v196, v196 row_ror:1 row_mask:0xf bank_mask:0xf
v_add_f32_dpp v197, v197, v197 row_ror:1 row_mask:0xf bank_mask:0xf
v_add_f32_dpp v198, v198, v198 row_ror:1 row_mask:0xf bank_mask:0xf
v_add_f32_dpp v199, v199, v199 row_ror:1 row_mask:0xf bank_mask:0xf
v_add_f32_dpp v200, v200, v200 row_ror:1 row_mask:0xf bank_mask:0xf
v_add_f32_dpp v201, v201, v201 row_ror:1 row_mask:0xf bank_mask:0xf
v_add_f32_dpp v202, v202, v202 row_ror:1 row_mask:0xf bank_mask:0xf
v_add_f32_dpp v203, v203, v203 row_ror:1 row_mask:0xf bank_mask:0xf
v_add_f32_dpp v204, v204, v204 row_ror:1 row_mask:0xf bank_mask:0xf
v_add_f32_dpp v205, v205, v205 row_ror:1 row_mask:0xf bank_mask:0xf
v_add_f32_dpp v206, v206, v206 row_ror:1 row_mask:0xf bank_mask:0xf
v_add_f32_dpp v207, v207, v207 row_ror:1 row_mask:0xf bank_mask:0xf
s_nop 1
v_max3_f32 v28, v192, v193, v194
v_max3_f32 v28, v28, v195, v196
v_max3_f32 v28, v28, v197, v198
v_max3_f32 v28, v28, v199, v200
v_max3_f32 v28, v28, v201, v202
v_max3_f32 v28, v28, v203, v204
v_max3_f32 v28, v28, v205, v206
v_max_f32 v28, v28, v207
s_nop 0
v_readlane_b32 s60, v28, 0
v_readlane_b32 s61, v28, 16
v_readlane_b32 s62, v28, 32
v_readlane_b32 s63, v28, 48
s_nop 1
v_mov_b32 v30, s60
v_max_f32 v30, s61, v30
v_max_f32 v30, s62, v30
v_max_f32 v30, s63, v30
v_mul_f32 v30, s58, v30
v_fma_f32 v192, v192, s58, -v30
v_fma_f32 v193, v193, s58, -v30
v_fma_f32 v194, v194, s58, -v30
v_fma_f32 v195, v195, s58, -v30
v_fma_f32 v196, v196, s58, -v30
v_fma_f32 v197, v197, s58, -v30
v_fma_f32 v198, v198, s58, -v30
v_fma_f32 v199, v199, s58, -v30
v_fma_f32 v200, v200, s58, -v30
v_fma_f32 v201, v201, s58, -v30
v_fma_f32 v202, v202, s58, -v30
v_fma_f32 v203, v203, s58, -v30
v_fma_f32 v204, v204, s58, -v30
v_fma_f32 v205, v205, s58, -v30
v_fma_f32 v206, v206, s58, -v30
v_fma_f32 v207, v207, s58, -v30
v_exp_f32 v192, v192
v_exp_f32 v193, v193
v_exp_f32 v194, v194
v_exp_f32 v195, v195
v_exp_f32 v196, v196
v_exp_f32 v197, v197
v_exp_f32 v198, v198
v_exp_f32 v199, v199
v_exp_f32 v200, v200
v_exp_f32 v201, v201
v_exp_f32 v202, v202
v_exp_f32 v203, v203
v_exp_f32 v204, v204
v_exp_f32 v205, v205
v_exp_f32 v206, v206
v_exp_f32 v207, v207
s_nop 0
v_add_f32 v208, v192, v193
v_add_f32 v209, v194, v195
v_add_f32 v210, v196, v197
v_add_f32 v211, v198, v199
v_add_f32 v212, v200, v201
v_add_f32 v213, v202, v203
v_add_f32 v214, v204, v205
v_add_f32 v215, v206, v207
v_add_f32 v208, v208, v212
v_add_f32 v209, v209, v213
v_add_f32 v210, v210, v214
v_add_f32 v211, v211, v215
v_add_f32 v208, v208, v210
v_add_f32 v209, v209, v211
v_add_f32 v28, v208, v209
s_nop 0
v_readlane_b32 s60, v28, 0
v_readlane_b32 s61, v28, 16
v_readlane_b32 s62, v28, 32
v_readlane_b32 s63, v28, 48
v_cvt_pk_bf16_f32 v29, v192, v192
v_and_b32 v64, v29, v20
v_and_b32 v65, v29, v21
v_and_b32 v66, v29, v22
v_and_b32 v67, v29, v23
v_cvt_pk_bf16_f32 v29, v193, v193
v_and_b32 v68, v29, v20
v_and_b32 v69, v29, v21
v_and_b32 v70, v29, v22
v_and_b32 v71, v29, v23
v_cvt_pk_bf16_f32 v29, v194, v194
v_and_b32 v72, v29, v20
v_and_b32 v73, v29, v21
v_and_b32 v74, v29, v22
v_and_b32 v75, v29, v23
v_cvt_pk_bf16_f32 v29, v195, v195
v_and_b32 v76, v29, v20
v_and_b32 v77, v29, v21
v_and_b32 v78, v29, v22
v_and_b32 v79, v29, v23
v_cvt_pk_bf16_f32 v29, v196, v196
v_and_b32 v80, v29, v20
v_and_b32 v81, v29, v21
v_and_b32 v82, v29, v22
v_and_b32 v83, v29, v23
v_cvt_pk_bf16_f32 v29, v197, v197
v_and_b32 v84, v29, v20
v_and_b32 v85, v29, v21
v_and_b32 v86, v29, v22
v_and_b32 v87, v29, v23
v_cvt_pk_bf16_f32 v29, v198, v198
v_and_b32 v88, v29, v20
v_and_b32 v89, v29, v21
v_and_b32 v90, v29, v22
v_and_b32 v91, v29, v23
v_cvt_pk_bf16_f32 v29, v199, v199
v_and_b32 v92, v29, v20
v_and_b32 v93, v29, v21
v_and_b32 v94, v29, v22
v_and_b32 v95, v29, v23
v_cvt_pk_bf16_f32 v29, v200, v200
v_and_b32 v96, v29, v20
v_and_b32 v97, v29, v21
v_and_b32 v98, v29, v22
v_and_b32 v99, v29, v23
v_cvt_pk_bf16_f32 v29, v201, v201
v_and_b32 v100, v29, v20
v_and_b32 v101, v29, v21
v_and_b32 v102, v29, v22
v_and_b32 v103, v29, v23
v_cvt_pk_bf16_f32 v29, v202, v202
v_and_b32 v104, v29, v20
v_and_b32 v105, v29, v21
v_and_b32 v106, v29, v22
v_and_b32 v107, v29, v23
v_cvt_pk_bf16_f32 v29, v203, v203
v_and_b32 v108, v29, v20
v_and_b32 v109, v29, v21
v_and_b32 v110, v29, v22
v_and_b32 v111, v29, v23
v_cvt_pk_bf16_f32 v29, v204, v204
v_and_b32 v112, v29, v20
v_and_b32 v113, v29, v21
v_and_b32 v114, v29, v22
v_and_b32 v115, v29, v23
v_cvt_pk_bf16_f32 v29, v205, v205
v_and_b32 v116, v29, v20
v_and_b32 v117, v29, v21
v_and_b32 v118, v29, v22
v_and_b32 v119, v29, v23
v_cvt_pk_bf16_f32 v29, v206, v206
v_and_b32 v120, v29, v20
v_and_b32 v121, v29, v21
v_and_b32 v122, v29, v22
v_and_b32 v123, v29, v23
v_cvt_pk_bf16_f32 v29, v207, v207
v_and_b32 v124, v29, v20
v_and_b32 v125, v29, v21
v_and_b32 v126, v29, v22
v_and_b32 v127, v29, v23
v_mov_b32 v31, s60
v_add_f32 v31, s61, v31
v_add_f32 v31, s62, v31
v_add_f32 v31, s63, v31
s_mov_b32 s79, 1
L_k1_pv:
s_nop 1
s_waitcnt vmcnt(15)
v_mfma_f32_16x16x32_bf16 v[40:43], v[64:67], v[128:131], 0
s_waitcnt vmcnt(14)
v_mfma_f32_16x16x32_bf16 v[40:43], v[68:71], v[132:135], v[40:43]
s_waitcnt vmcnt(13)
v_mfma_f32_16x16x32_bf16 v[40:43], v[72:75], v[136:139], v[40:43]
s_waitcnt vmcnt(12)
v_mfma_f32_16x16x32_bf16 v[40:43], v[76:79], v[140:143], v[40:43]
s_waitcnt vmcnt(11)
v_mfma_f32_16x16x32_bf16 v[40:43], v[80:83], v[144:147], v[40:43]
s_waitcnt vmcnt(10)
v_mfma_f32_16x16x32_bf16 v[40:43], v[84:87], v[148:151], v[40:43]
s_waitcnt vmcnt(9)
v_mfma_f32_16x16x32_bf16 v[40:43], v[88:91], v[152:155], v[40:43]
s_waitcnt vmcnt(8)
v_mfma_f32_16x16x32_bf16 v[40:43], v[92:95], v[156:159], v[40:43]
s_waitcnt vmcnt(7)
v_mfma_f32_16x16x32_bf16 v[40:43], v[96:99], v[160:163], v[40:43]
s_waitcnt vmcnt(6)
v_mfma_f32_16x16x32_bf16 v[40:43], v[100:103], v[164:167], v[40:43]
s_waitcnt vmcnt(5)
v_mfma_f32_16x16x32_bf16 v[40:43], v[104:107], v[168:171], v[40:43]
s_waitcnt vmcnt(4)
v_mfma_f32_16x16x32_bf16 v[40:43], v[108:111], v[172:175], v[40:43]
s_waitcnt vmcnt(3)
v_mfma_f32_16x16x32_bf16 v[40:43], v[112:115], v[176:179], v[40:43]
s_waitcnt vmcnt(2)
v_mfma_f32_16x16x32_bf16 v[40:43], v[116:119], v[180:183], v[40:43]
s_waitcnt vmcnt(1)
v_mfma_f32_16x16x32_bf16 v[40:43], v[120:123], v[184:187], v[40:43]
s_waitcnt vmcnt(0)
v_mfma_f32_16x16x32_bf16 v[40:43], v[124:127], v[188:191], v[40:43]
s_mov_b32 exec_lo, -1
s_mov_b32 exec_hi, 0
ds_write_b64 v11, v[30:31] offset:2560
s_nop 5
ds_write_b128 v10, v[40:43] offset:512
s_mov_b64 exec, -1
s_waitcnt lgkmcnt(0)
s_barrier
s_endpgm
L_k1_hq:
v_mul_u32_u24 v4, 0x28000, v3
v_lshl_add_u32 v4, v2, 4, v4
v_lshrrev_b32 v9, 3, v2
v_mul_u32_u24 v5, 1280, v9
v_mul_u32_u24 v29, 40, v3
v_add_u32 v5, v5, v29
s_mul_i32 s48, s45, 655360
s_lshl_b32 s55, s44, 8
s_add_u32 s48, s48, s55
s_mul_i32 s51, s45, 160
s_mov_b32 s56, 0x01000100
s_mov_b32 s57, 0x03020302
v_mov_b32 v35, 2624
s_waitcnt lgkmcnt(0)
s_mov_b32 s20, s4
s_mov_b32 s21, s5
s_mov_b32 s22, 2560
s_mov_b32 s23, 0x00020000
s_mov_b32 s32, s10
s_mov_b32 s33, s11
s_mov_b32 s34, 5242880
s_mov_b32 s35, 0x00020000
buffer_load_dwordx2 v[10:11], v5, s[20:23], s51 offen offset:0
buffer_load_dwordx2 v[12:13], v5, s[20:23], s51 offen offset:8
buffer_load_dwordx2 v[14:15], v5, s[20:23], s51 offen offset:16
buffer_load_dwordx2 v[16:17], v5, s[20:23], s51 offen offset:24
buffer_load_dwordx2 v[18:19], v5, s[20:23], s51 offen offset:32
buffer_load_dwordx4 v[64:67], v4, s[32:35], s48 offen nt
s_add_u32 s48, s48, 8192
buffer_load_dwordx4 v[68:71], v4, s[32:35], s48 offen nt
s_add_u32 s48, s48, 8192
buffer_load_dwordx4 v[72:75], v4, s[32:35], s48 offen nt
s_add_u32 s48, s48, 8192
buffer_load_dwordx4 v[76:79], v4, s[32:35], s48 offen nt
s_add_u32 s48, s48, 8192
buffer_load_dwordx4 v[80:83], v4, s[32:35], s48 offen nt
s_add_u32 s48, s48, 8192
buffer_load_dwordx4 v[84:87], v4, s[32:35], s48 offen nt
s_add_u32 s48, s48, 8192
buffer_load_dwordx4 v[88:91], v4, s[32:35], s48 offen nt
s_add_u32 s48, s48, 8192
buffer_load_dwordx4 v[92:95], v4, s[32:35], s48 offen nt
s_add_u32 s48, s48, 8192
buffer_load_dwordx4 v[96:99], v4, s[32:35], s48 offen nt
s_add_u32 s48, s48, 8192
buffer_load_dwordx4 v[100:103], v4, s[32:35], s48 offen nt
s_add_u32 s48, s48, 8192
buffer_load_dwordx4 v[104:107], v4, s[32:35], s48 offen nt
s_add_u32 s48, s48, 8192
buffer_load_dwordx4 v[108:111], v4, s[32:35], s48 offen nt
s_add_u32 s48, s48, 8192
buffer_load_dwordx4 v[112:115], v4, s[32:35], s48 offen nt
s_add_u32 s48, s48, 8192
buffer_load_dwordx4 v[116:119], v4, s[32:35], s48 offen nt
s_add_u32 s48, s48, 8192
buffer_load_dwordx4 v[120:123], v4, s[32:35], s48 offen nt
s_add_u32 s48, s48, 8192
buffer_load_dwordx4 v[124:127], v4, s[32:35], s48 offen nt
s_add_u32 s48, s48, 8192
buffer_load_dwordx4 v[128:131], v4, s[32:35], s48 offen nt
s_add_u32 s48, s48, 8192
buffer_load_dwordx4 v[132:135], v4, s[32:35], s48 offen nt
s_add_u32 s48, s48, 8192
buffer_load_dwordx4 v[136:139], v4, s[32:35], s48 offen nt
s_add_u32 s48, s48, 8192
buffer_load_dwordx4 v[140:143], v4, s[32:35], s48 offen nt
ds_write_b32 v35, v31
s_mov_b32 s60, s16
s_mov_b32 s61, s17
s_mov_b32 s62, 256
s_mov_b32 s63, 0x00020000
buffer_load_dword v32, v31, s[60:63], 0 offen sc1
s_waitcnt lgkmcnt(0)
s_barrier
s_mov_b32 s40, s18
s_mov_b32 s41, s19
s_mov_b32 s42, 3407872
s_mov_b32 s43, 0x00020000
v_and_b32 v28, 1, v2
v_lshlrev_b32 v28, 4, v28
v_mov_b32 v29, 0xffff
v_lshlrev_b32 v28, v28, v29
v_bfe_u32 v29, v2, 1, 2
v_cmp_eq_u32 vcc, 0, v29
s_nop 1
v_cndmask_b32 v20, 0, v28, vcc
v_cmp_eq_u32 vcc, 1, v29
s_nop 1
v_cndmask_b32 v21, 0, v28, vcc
v_cmp_eq_u32 vcc, 2, v29
s_nop 1
v_cndmask_b32 v22, 0, v28, vcc
v_cmp_eq_u32 vcc, 3, v29
s_nop 1
v_cndmask_b32 v23, 0, v28, vcc
s_lshl_b32 s52, s44, 14
s_add_u32 s52, s52, 1310720
s_lshl_b32 s55, s45, 11
s_add_u32 s55, s55, s52
s_mov_b32 s90, 0
s_mov_b32 s91, 0
s_add_u32 s92, s55, 524288
s_add_u32 s80, s52, 0
s_add_u32 s81, s52, 0
s_add_u32 s82, s52, 4096
s_add_u32 s83, s52, 4096
s_add_u32 s84, s52, 8192
s_add_u32 s85, s52, 8192
s_add_u32 s86, s52, 12288
s_add_u32 s87, s52, 12288
v_lshlrev_b32 v30, 5, v1
v_lshrrev_b32 v36, 1, v3
v_lshlrev_b32 v36, 8, v36
v_lshl_add_u32 v36, v2, 4, v36
v_and_b32 v34, 1, v3
v_lshl_add_u32 v36, v34, 3, v36
s_waitcnt vmcnt(21)
v_perm_b32 v28, v10, v10, s56
v_and_b32 v24, v28, v20
v_and_b32 v25, v28, v21
v_and_b32 v26, v28, v22
v_and_b32 v27, v28, v23
s_waitcnt vmcnt(20)
s_nop 0
v_mfma_f32_16x16x32_bf16 v[40:43], v[24:27], v[64:67], 0
v_perm_b32 v28, v10, v10, s57
v_and_b32 v24, v28, v20
v_and_b32 v25, v28, v21
v_and_b32 v26, v28, v22
v_and_b32 v27, v28, v23
s_waitcnt vmcnt(19)
s_nop 0
v_mfma_f32_16x16x32_bf16 v[40:43], v[24:27], v[68:71], v[40:43]
v_perm_b32 v28, v11, v11, s56
v_and_b32 v24, v28, v20
v_and_b32 v25, v28, v21
v_and_b32 v26, v28, v22
v_and_b32 v27, v28, v23
s_waitcnt vmcnt(18)
s_nop 0
v_mfma_f32_16x16x32_bf16 v[40:43], v[24:27], v[72:75], v[40:43]
v_perm_b32 v28, v11, v11, s57
v_and_b32 v24, v28, v20
v_and_b32 v25, v28, v21
v_and_b32 v26, v28, v22
v_and_b32 v27, v28, v23
s_waitcnt vmcnt(17)
s_nop 0
v_mfma_f32_16x16x32_bf16 v[40:43], v[24:27], v[76:79], v[40:43]
v_perm_b32 v28, v12, v12, s56
v_and_b32 v24, v28, v20
v_and_b32 v25, v28, v21
v_and_b32 v26, v28, v22
v_and_b32 v27, v28, v23
s_waitcnt vmcnt(16)
s_nop 0
v_mfma_f32_16x16x32_bf16 v[40:43], v[24:27], v[80:83], v[40:43]
v_perm_b32 v28, v12, v12, s57
v_and_b32 v24, v28, v20
v_and_b32 v25, v28, v21
v_and_b32 v26, v28, v22
v_and_b32 v27, v28, v23
s_waitcnt vmcnt(15)
s_nop 0
v_mfma_f32_16x16x32_bf16 v[40:43], v[24:27], v[84:87], v[40:43]
v_perm_b32 v28, v13, v13, s56
v_and_b32 v24, v28, v20
v_and_b32 v25, v28, v21
v_and_b32 v26, v28, v22
v_and_b32 v27, v28, v23
s_waitcnt vmcnt(14)
s_nop 0
v_mfma_f32_16x16x32_bf16 v[40:43], v[24:27], v[88:91], v[40:43]
v_perm_b32 v28, v13, v13, s57
v_and_b32 v24, v28, v20
v_and_b32 v25, v28, v21
v_and_b32 v26, v28, v22
v_and_b32 v27, v28, v23
s_waitcnt vmcnt(13)
s_nop 0
v_mfma_f32_16x16x32_bf16 v[40:43], v[24:27], v[92:95], v[40:43]
v_perm_b32 v28, v14, v14, s56
v_and_b32 v24, v28, v20
v_and_b32 v25, v28, v21
v_and_b32 v26, v28, v22
v_and_b32 v27, v28, v23
s_waitcnt vmcnt(12)
s_nop 0
v_mfma_f32_16x16x32_bf16 v[40:43], v[24:27], v[96:99], v[40:43]
v_perm_b32 v28, v14, v14, s57
v_and_b32 v24, v28, v20
v_and_b32 v25, v28, v21
v_and_b32 v26, v28, v22
v_and_b32 v27, v28, v23
s_waitcnt vmcnt(11)
s_nop 0
v_mfma_f32_16x16x32_bf16 v[40:43], v[24:27], v[100:103], v[40:43]
v_perm_b32 v28, v15, v15, s56
v_and_b32 v24, v28, v20
v_and_b32 v25, v28, v21
v_and_b32 v26, v28, v22
v_and_b32 v27, v28, v23
s_waitcnt vmcnt(10)
s_nop 0
v_mfma_f32_16x16x32_bf16 v[40:43], v[24:27], v[104:107], v[40:43]
v_perm_b32 v28, v15, v15, s57
v_and_b32 v24, v28, v20
v_and_b32 v25, v28, v21
v_and_b32 v26, v28, v22
v_and_b32 v27, v28, v23
s_waitcnt vmcnt(9)
s_nop 0
v_mfma_f32_16x16x32_bf16 v[40:43], v[24:27], v[108:111], v[40:43]
v_perm_b32 v28, v16, v16, s56
v_and_b32 v24, v28, v20
v_and_b32 v25, v28, v21
v_and_b32 v26, v28, v22
v_and_b32 v27, v28, v23
s_waitcnt vmcnt(8)
s_nop 0
v_mfma_f32_16x16x32_bf16 v[40:43], v[24:27], v[112:115], v[40:43]
v_perm_b32 v28, v16, v16, s57
v_and_b32 v24, v28, v20
v_and_b32 v25, v28, v21
v_and_b32 v26, v28, v22
v_and_b32 v27, v28, v23
s_waitcnt vmcnt(7)
s_nop 0
v_mfma_f32_16x16x32_bf16 v[40:43], v[24:27], v[116:119], v[40:43]
v_perm_b32 v28, v17, v17, s56
v_and_b32 v24, v28, v20
v_and_b32 v25, v28, v21
v_and_b32 v26, v28, v22
v_and_b32 v27, v28, v23
s_waitcnt vmcnt(6)
s_nop 0
v_mfma_f32_16x16x32_bf16 v[40:43], v[24:27], v[120:123], v[40:43]
v_perm_b32 v28, v17, v17, s57
v_and_b32 v24, v28, v20
v_and_b32 v25, v28, v21
v_and_b32 v26, v28, v22
v_and_b32 v27, v28, v23
s_waitcnt vmcnt(5)
s_nop 0
v_mfma_f32_16x16x32_bf16 v[40:43], v[24:27], v[124:127], v[40:43]
v_perm_b32 v28, v18, v18, s56
v_and_b32 v24, v28, v20
v_and_b32 v25, v28, v21
v_and_b32 v26, v28, v22
v_and_b32 v27, v28, v23
s_waitcnt vmcnt(4)
s_nop 0
v_mfma_f32_16x16x32_bf16 v[40:43], v[24:27], v[128:131], v[40:43]
v_perm_b32 v28, v18, v18, s57
v_and_b32 v24, v28, v20
v_and_b32 v25, v28, v21
v_and_b32 v26, v28, v22
v_and_b32 v27, v28, v23
s_waitcnt vmcnt(3)
s_nop 0
v_mfma_f32_16x16x32_bf16 v[40:43], v[24:27], v[132:135], v[40:43]
v_perm_b32 v28, v19, v19, s56
v_and_b32 v24, v28, v20
v_and_b32 v25, v28, v21
v_and_b32 v26, v28, v22
v_and_b32 v27, v28, v23
s_waitcnt vmcnt(2)
s_nop 0
v_mfma_f32_16x16x32_bf16 v[40:43], v[24:27], v[136:139], v[40:43]
v_perm_b32 v28, v19, v19, s57
v_and_b32 v24, v28, v20
v_and_b32 v25, v28, v21
v_and_b32 v26, v28, v22
v_and_b32 v27, v28, v23
s_waitcnt vmcnt(1)
s_nop 0
v_mfma_f32_16x16x32_bf16 v[40:43], v[24:27], v[140:143], v[40:43]
s_waitcnt vmcnt(0)
v_readfirstlane_b32 s59, v32
s_nop 3
s_cmp_lg_u32 s59, 0
s_cbranch_scc1 L_k1_have_nonce
L_k1_npoll_q:
buffer_load_dword v28, v31, s[60:63], 0 offen sc1
s_waitcnt vmcnt(0)
v_readfirstlane_b32 s59, v28
s_nop 3
s_cmp_eq_u32 s59, 0
s_cbranch_scc1 L_k1_npoll_q
L_k1_have_nonce:
s_nop 1
v_mov_b32 v208, v40
v_mov_b32 v209, s59
v_mov_b32 v210, v41
v_mov_b32 v211, s59
v_mov_b32 v212, v42
v_mov_b32 v213, s59
v_mov_b32 v214, v43
v_mov_b32 v215, s59
buffer_store_dwordx4 v[208:211], v30, s[40:43], s55 offen
buffer_store_dwordx4 v[212:215], v30, s[40:43], s55 offen offset:16
L_k1_xq:
buffer_load_dwordx4 v[64:67], v30, s[40:43], s80 offen offset:0 sc1
buffer_load_dwordx4 v[68:71], v30, s[40:43], s80 offen offset:16 sc1
buffer_load_dwordx4 v[72:75], v30, s[40:43], s81 offen offset:2048 sc1
buffer_load_dwordx4 v[76:79], v30, s[40:43], s81 offen offset:2064 sc1
buffer_load_dwordx4 v[80:83], v30, s[40:43], s82 offen offset:0 sc1
buffer_load_dwordx4 v[84:87], v30, s[40:43], s82 offen offset:16 sc1
buffer_load_dwordx4 v[88:91], v30, s[40:43], s83 offen offset:2048 sc1
buffer_load_dwordx4 v[92:95], v30, s[40:43], s83 offen offset:2064 sc1
buffer_load_dwordx4 v[96:99], v30, s[40:43], s84 offen offset:0 sc1
buffer_load_dwordx4 v[100:103], v30, s[40:43], s84 offen offset:16 sc1
buffer_load_dwordx4 v[104:107], v30, s[40:43], s85 offen offset:2048 sc1
buffer_load_dwordx4 v[108:111], v30, s[40:43], s85 offen offset:2064 sc1
buffer_load_dwordx4 v[112:115], v30, s[40:43], s86 offen offset:0 sc1
buffer_load_dwordx4 v[116:119], v30, s[40:43], s86 offen offset:16 sc1
buffer_load_dwordx4 v[120:123], v30, s[40:43], s87 offen offset:2048 sc1
buffer_load_dwordx4 v[124:127], v30, s[40:43], s87 offen offset:2064 sc1
s_waitcnt vmcnt(0)
v_min3_u32 v28, v65, v67, v69
v_max3_u32 v29, v65, v67, v69
v_min3_u32 v28, v28, v71, v73
v_max3_u32 v29, v29, v71, v73
v_min3_u32 v28, v28, v75, v77
v_max3_u32 v29, v29, v75, v77
v_min3_u32 v28, v28, v79, v81
v_max3_u32 v29, v29, v79, v81
v_min3_u32 v28, v28, v83, v85
v_max3_u32 v29, v29, v83, v85
v_min3_u32 v28, v28, v87, v89
v_max3_u32 v29, v29, v87, v89
v_min3_u32 v28, v28, v91, v93
v_max3_u32 v29, v29, v91, v93
v_min3_u32 v28, v28, v95, v97
v_max3_u32 v29, v29, v95, v97
v_min3_u32 v28, v28, v99, v101
v_max3_u32 v29, v29, v99, v101
v_min3_u32 v28, v28, v103, v105
v_max3_u32 v29, v29, v103, v105
v_min3_u32 v28, v28, v107, v109
v_max3_u32 v29, v29, v107, v109
v_min3_u32 v28, v28, v111, v113
v_max3_u32 v29, v29, v111, v113
v_min3_u32 v28, v28, v115, v117
v_max3_u32 v29, v29, v115, v117
v_min3_u32 v28, v28, v119, v121
v_max3_u32 v29, v29, v119, v121
v_min3_u32 v28, v28, v123, v125
v_max3_u32 v29, v29, v123, v125
v_min_u32 v28, v28, v127
v_max_u32 v29, v29, v127
v_xor_b32 v28, s59, v28
v_xor_b32 v29, s59, v29
v_or_b32 v28, v28, v29
v_cmp_ne_u32 vcc, 0, v28
s_nop 1
s_cmp_lg_u64 vcc, 0
s_cbranch_scc1 L_k1_xq_retry
s_cmp_lg_u32 s91, 0
s_cbranch_scc1 L_k1_xq_done
buffer_store_dwordx4 v[208:211], v30, s[40:43], s92 offen sc1
buffer_store_dwordx4 v[212:215], v30, s[40:43], s92 offen offset:16 sc1
s_branch L_k1_xq_done
L_k1_xq_retry:
s_add_u32 s90, s90, 1
s_cmp_lt_u32 s90, 8
s_cbranch_scc1 L_k1_xq_sl
s_cmp_lg_u32 s91, 0
s_cbranch_scc1 L_k1_xq_pubd
buffer_store_dwordx4 v[208:211], v30, s[40:43], s92 offen sc1
buffer_store_dwordx4 v[212:215], v30, s[40:43], s92 offen offset:16 sc1
s_mov_b32 s91, 1
L_k1_xq_pubd:
v_and_b32 v27, 7, v1
v_lshlrev_b32 v27, 11, v27
v_lshrrev_b32 v26, 3, v1
v_lshlrev_b32 v26, 19, v26
v_add_u32 v27, v27, v26
s_mov_b32 exec_lo, 0xffff
s_mov_b32 exec_hi, 0
buffer_load_dword v28, v27, s[40:43], s52 offen offset:2044 sc1
s_waitcnt vmcnt(0)
v_cmp_eq_u32 vcc, s59, v28
s_nop 1
s_mov_b32 s88, vcc_lo
s_mov_b64 exec, -1
s_bitcmp1_b32 s88, 8
s_cselect_b32 s80, 524288, 0
s_add_u32 s80, s80, s52
s_bitcmp1_b32 s88, 9
s_cselect_b32 s81, 524288, 0
s_add_u32 s81, s81, s52
s_bitcmp1_b32 s88, 10
s_cselect_b32 s82, 524288, 0
s_add_u32 s82, s82, s52
s_add_u32 s82, s82, 4096
s_bitcmp1_b32 s88, 11
s_cselect_b32 s83, 524288, 0
s_add_u32 s83, s83, s52
s_add_u32 s83, s83, 4096
s_bitcmp1_b32 s88, 12
s_cselect_b32 s84, 524288, 0
s_add_u32 s84, s84, s52
s_add_u32 s84, s84, 8192
s_bitcmp1_b32 s88, 13
s_cselect_b32 s85, 524288, 0
s_add_u32 s85, s85, s52
s_add_u32 s85, s85, 8192
s_bitcmp1_b32 s88, 14
s_cselect_b32 s86, 524288, 0
s_add_u32 s86, s86, s52
s_add_u32 s86, s86, 12288
s_bitcmp1_b32 s88, 15
s_cselect_b32 s87, 524288, 0
s_add_u32 s87, s87, s52
s_add_u32 s87, s87, 12288
L_k1_xq_sl:
s_sleep 8
s_branch L_k1_xq
L_k1_xq_done:
v_add_f32 v224, v64, v72
v_add_f32 v228, v80, v88
v_add_f32 v216, v96, v104
v_add_f32 v220, v112, v120
v_add_f32 v225, v66, v74
v_add_f32 v229, v82, v90
v_add_f32 v217, v98, v106
v_add_f32 v221, v114, v122
v_add_f32 v226, v68, v76
v_add_f32 v230, v84, v92
v_add_f32 v218, v100, v108
v_add_f32 v222, v116, v124
v_add_f32 v227, v70, v78
v_add_f32 v231, v86, v94
v_add_f32 v219, v102, v110
v_add_f32 v223, v118, v126
v_add_f32 v224, v224, v228
v_add_f32 v216, v216, v220
v_add_f32 v225, v225, v229
v_add_f32 v217, v217, v221
v_add_f32 v226, v226, v230
v_add_f32 v218, v218, v222
v_add_f32 v227, v227, v231
v_add_f32 v219, v219, v223
v_add_f32 v224, v224, v216
v_add_f32 v225, v225, v217
v_add_f32 v226, v226, v218
v_add_f32 v227, v227, v219
v_cvt_pk_bf16_f32 v32, v224, v225
v_cvt_pk_bf16_f32 v33, v226, v227
v_mov_b32 v34, 1
ds_write_b64 v36, v[32:33] offset:0
s_waitcnt lgkmcnt(0)
ds_write_b32 v35, v34
s_lshl_b32 s56, s44, 14
s_add_u32 s56, s56, 2883584
s_lshl_b32 s55, s45, 11
s_add_u32 s56, s56, s55
v_lshrrev_b32 v11, 5, v1
v_and_b32 v12, 31, v1
v_lshlrev_b32 v13, 10, v11
v_lshl_add_u32 v13, v12, 4, v13
v_lshlrev_b32 v14, 4, v11
v_mov_b32 v231, s59
v_mov_b32 v223, s59
s_waitcnt lgkmcnt(0)
s_barrier
ds_read_b128 v[208:211], v14 offset:2560
ds_read_b128 v[212:215], v13 offset:512
ds_read_b128 v[216:219], v13 offset:1024
s_waitcnt lgkmcnt(2)
v_max_f32 v221, v208, v210
v_sub_f32 v224, v208, v221
v_sub_f32 v225, v210, v221
v_exp_f32 v224, v224
v_exp_f32 v225, v225
s_waitcnt lgkmcnt(0)
v_mul_f32 v222, v224, v209
v_mul_f32 v228, v224, v212
v_mul_f32 v229, v224, v213
v_mul_f32 v230, v224, v214
v_mul_f32 v220, v224, v215
v_fmac_f32 v222, v225, v211
v_fmac_f32 v228, v225, v216
v_fmac_f32 v229, v225, v217
v_fmac_f32 v230, v225, v218
v_fmac_f32 v220, v225, v219
buffer_store_dwordx4 v[228:231], v30, s[40:43], s56 offen sc1
buffer_store_dwordx4 v[220:223], v30, s[40:43], s56 offen offset:16 sc1
s_endpgm
L_k1_ho:
v_mul_u32_u24 v8, 5120, v3
v_lshl_add_u32 v8, v2, 4, v8
s_lshl_b32 s53, s44, 7
s_lshl_b32 s55, s45, 4
s_add_u32 s53, s53, s55
s_mul_i32 s53, s53, 1280
s_add_u32 s54, s53, 2560
s_waitcnt lgkmcnt(0)
s_mov_b32 s60, s16
s_mov_b32 s61, s17
s_mov_b32 s62, 256
s_mov_b32 s63, 0x00020000
s_cmp_lg_u32 s2, 0
s_cbranch_scc1 L_k1_nonice
s_or_b32 s96, s96, 1
v_mov_b32 v30, s96
s_mov_b32 exec_lo, 1
s_mov_b32 exec_hi, 0
buffer_store_dword v30, v31, s[60:63], 0 offen sc1
s_mov_b64 exec, -1
L_k1_nonice:
s_mov_b32 s36, s12
s_mov_b32 s37, s13
s_mov_b32 s38, 5242880
s_mov_b32 s39, 0x00020000
s_mov_b32 s40, s18
s_mov_b32 s41, s19
s_mov_b32 s42, 3407872
s_mov_b32 s43, 0x00020000
s_barrier
buffer_load_dwordx4 v[64:67], v8, s[36:39], s53 offen offset:0 nt
buffer_load_dwordx4 v[68:71], v8, s[36:39], s53 offen offset:256 nt
buffer_load_dwordx4 v[72:75], v8, s[36:39], s53 offen offset:512 nt
buffer_load_dwordx4 v[76:79], v8, s[36:39], s53 offen offset:768 nt
buffer_load_dwordx4 v[80:83], v8, s[36:39], s53 offen offset:1024 nt
buffer_load_dwordx4 v[84:87], v8, s[36:39], s53 offen offset:1280 nt
buffer_load_dwordx4 v[88:91], v8, s[36:39], s53 offen offset:1536 nt
buffer_load_dwordx4 v[92:95], v8, s[36:39], s53 offen offset:1792 nt
buffer_load_dwordx4 v[96:99], v8, s[36:39], s53 offen offset:2048 nt
buffer_load_dwordx4 v[100:103], v8, s[36:39], s53 offen offset:2304 nt
buffer_load_dwordx4 v[104:107], v8, s[36:39], s54 offen offset:0 nt
buffer_load_dwordx4 v[108:111], v8, s[36:39], s54 offen offset:256 nt
buffer_load_dwordx4 v[112:115], v8, s[36:39], s54 offen offset:512 nt
buffer_load_dwordx4 v[116:119], v8, s[36:39], s54 offen offset:768 nt
buffer_load_dwordx4 v[120:123], v8, s[36:39], s54 offen offset:1024 nt
buffer_load_dwordx4 v[124:127], v8, s[36:39], s54 offen offset:1280 nt
buffer_load_dwordx4 v[128:131], v8, s[36:39], s54 offen offset:1536 nt
buffer_load_dwordx4 v[132:135], v8, s[36:39], s54 offen offset:1792 nt
buffer_load_dwordx4 v[136:139], v8, s[36:39], s54 offen offset:2048 nt
buffer_load_dwordx4 v[140:143], v8, s[36:39], s54 offen offset:2304 nt
v_and_b32 v28, 1, v2
v_lshlrev_b32 v28, 4, v28
v_mov_b32 v29, 0xffff
v_lshlrev_b32 v28, v28, v29
v_bfe_u32 v29, v2, 1, 2
v_cmp_eq_u32 vcc, 0, v29
s_nop 1
v_cndmask_b32 v20, 0, v28, vcc
v_cmp_eq_u32 vcc, 1, v29
s_nop 1
v_cndmask_b32 v21, 0, v28, vcc
v_cmp_eq_u32 vcc, 2, v29
s_nop 1
v_cndmask_b32 v22, 0, v28, vcc
v_cmp_eq_u32 vcc, 3, v29
s_nop 1
v_cndmask_b32 v23, 0, v28, vcc
s_lshl_b32 s52, s44, 14
s_add_u32 s52, s52, 2359296
s_lshl_b32 s55, s45, 11
s_add_u32 s56, s55, s52
s_mov_b32 s90, 0
s_mov_b32 s91, 0
s_add_u32 s92, s56, 524288
s_add_u32 s80, s52, 0
s_add_u32 s81, s52, 0
s_add_u32 s82, s52, 4096
s_add_u32 s83, s52, 4096
s_add_u32 s84, s52, 8192
s_add_u32 s85, s52, 8192
s_add_u32 s86, s52, 12288
s_add_u32 s87, s52, 12288
v_lshlrev_b32 v30, 5, v1
v_lshrrev_b32 v9, 3, v2
v_lshlrev_b32 v10, 10, v9
v_lshl_add_u32 v10, v3, 5, v10
s_lshl_b32 s55, s45, 7
v_add_u32 v10, s55, v10
v_lshrrev_b32 v11, 5, v1
v_and_b32 v12, 31, v1
v_lshlrev_b32 v13, 10, v11
v_lshl_add_u32 v13, v12, 4, v13
v_lshlrev_b32 v14, 4, v11
s_lshl_b32 s57, s44, 3
s_add_u32 s57, s57, s45
s_mul_i32 s57, s57, 5120
v_lshrrev_b32 v15, 1, v3
v_mul_u32_u24 v15, 2560, v15
v_lshl_add_u32 v15, v2, 5, v15
v_and_b32 v16, 1, v3
v_lshl_add_u32 v15, v16, 4, v15
L_k1_npoll_o:
buffer_load_dword v28, v31, s[60:63], 0 offen sc1
s_waitcnt vmcnt(0)
v_readfirstlane_b32 s59, v28
s_nop 3
s_cmp_eq_u32 s59, 0
s_cbranch_scc1 L_k1_npoll_o
s_nop 1
v_mov_b32 v231, s59
v_mov_b32 v223, s59
s_barrier
ds_read_b128 v[208:211], v14 offset:2560
ds_read_b128 v[212:215], v13 offset:512
ds_read_b128 v[216:219], v13 offset:1024
s_waitcnt lgkmcnt(2)
v_max_f32 v221, v208, v210
v_sub_f32 v224, v208, v221
v_sub_f32 v225, v210, v221
v_exp_f32 v224, v224
v_exp_f32 v225, v225
s_waitcnt lgkmcnt(0)
v_mul_f32 v222, v224, v209
v_mul_f32 v228, v224, v212
v_mul_f32 v229, v224, v213
v_mul_f32 v230, v224, v214
v_mul_f32 v220, v224, v215
v_fmac_f32 v222, v225, v211
v_fmac_f32 v228, v225, v216
v_fmac_f32 v229, v225, v217
v_fmac_f32 v230, v225, v218
v_fmac_f32 v220, v225, v219
buffer_store_dwordx4 v[228:231], v30, s[40:43], s56 offen
buffer_store_dwordx4 v[220:223], v30, s[40:43], s56 offen offset:16
L_k1_xo:
buffer_load_dwordx4 v[144:147], v10, s[40:43], s80 offen offset:0 sc1
buffer_load_dwordx4 v[148:151], v10, s[40:43], s80 offen offset:16 sc1
buffer_load_dwordx4 v[152:155], v10, s[40:43], s81 offen offset:2048 sc1
buffer_load_dwordx4 v[156:159], v10, s[40:43], s81 offen offset:2064 sc1
buffer_load_dwordx4 v[160:163], v10, s[40:43], s82 offen offset:0 sc1
buffer_load_dwordx4 v[164:167], v10, s[40:43], s82 offen offset:16 sc1
buffer_load_dwordx4 v[168:171], v10, s[40:43], s83 offen offset:2048 sc1
buffer_load_dwordx4 v[172:175], v10, s[40:43], s83 offen offset:2064 sc1
buffer_load_dwordx4 v[176:179], v10, s[40:43], s84 offen offset:0 sc1
buffer_load_dwordx4 v[180:183], v10, s[40:43], s84 offen offset:16 sc1
buffer_load_dwordx4 v[184:187], v10, s[40:43], s85 offen offset:2048 sc1
buffer_load_dwordx4 v[188:191], v10, s[40:43], s85 offen offset:2064 sc1
buffer_load_dwordx4 v[192:195], v10, s[40:43], s86 offen offset:0 sc1
buffer_load_dwordx4 v[196:199], v10, s[40:43], s86 offen offset:16 sc1
buffer_load_dwordx4 v[200:203], v10, s[40:43], s87 offen offset:2048 sc1
buffer_load_dwordx4 v[204:207], v10, s[40:43], s87 offen offset:2064 sc1
s_waitcnt vmcnt(0)
v_min3_u32 v28, v147, v151, v155
v_max3_u32 v29, v147, v151, v155
v_min3_u32 v28, v28, v159, v163
v_max3_u32 v29, v29, v159, v163
v_min3_u32 v28, v28, v167, v171
v_max3_u32 v29, v29, v167, v171
v_min3_u32 v28, v28, v175, v179
v_max3_u32 v29, v29, v175, v179
v_min3_u32 v28, v28, v183, v187
v_max3_u32 v29, v29, v183, v187
v_min3_u32 v28, v28, v191, v195
v_max3_u32 v29, v29, v191, v195
v_min3_u32 v28, v28, v199, v203
v_max3_u32 v29, v29, v199, v203
v_min_u32 v28, v28, v207
v_max_u32 v29, v29, v207
v_xor_b32 v28, s59, v28
v_xor_b32 v29, s59, v29
v_or_b32 v28, v28, v29
v_cmp_ne_u32 vcc, 0, v28
s_nop 1
s_cmp_lg_u64 vcc, 0
s_cbranch_scc1 L_k1_xo_retry
s_branch L_k1_xo_done
L_k1_xo_retry:
s_add_u32 s90, s90, 1
s_cmp_lt_u32 s90, 24
s_cbranch_scc1 L_k1_xo_sl
v_and_b32 v27, 7, v1
v_lshlrev_b32 v27, 11, v27
v_lshrrev_b32 v26, 3, v1
v_lshlrev_b32 v26, 19, v26
v_add_u32 v27, v27, v26
s_mov_b32 exec_lo, 0xffff
s_mov_b32 exec_hi, 0
buffer_load_dword v28, v27, s[40:43], s52 offen offset:2044 sc1
s_waitcnt vmcnt(0)
v_cmp_eq_u32 vcc, s59, v28
s_nop 1
s_mov_b32 s88, vcc_lo
s_mov_b64 exec, -1
s_bitcmp1_b32 s88, 8
s_cselect_b32 s80, 524288, 0
s_add_u32 s80, s80, s52
s_bitcmp1_b32 s88, 9
s_cselect_b32 s81, 524288, 0
s_add_u32 s81, s81, s52
s_bitcmp1_b32 s88, 10
s_cselect_b32 s82, 524288, 0
s_add_u32 s82, s82, s52
s_add_u32 s82, s82, 4096
s_bitcmp1_b32 s88, 11
s_cselect_b32 s83, 524288, 0
s_add_u32 s83, s83, s52
s_add_u32 s83, s83, 4096
s_bitcmp1_b32 s88, 12
s_cselect_b32 s84, 524288, 0
s_add_u32 s84, s84, s52
s_add_u32 s84, s84, 8192
s_bitcmp1_b32 s88, 13
s_cselect_b32 s85, 524288, 0
s_add_u32 s85, s85, s52
s_add_u32 s85, s85, 8192
s_bitcmp1_b32 s88, 14
s_cselect_b32 s86, 524288, 0
s_add_u32 s86, s86, s52
s_add_u32 s86, s86, 12288
s_bitcmp1_b32 s88, 15
s_cselect_b32 s87, 524288, 0
s_add_u32 s87, s87, s52
s_add_u32 s87, s87, 12288
L_k1_xo_sl:
s_branch L_k1_xo
L_k1_xo_done:
v_max3_f32 v28, v149, v157, v165
v_max3_f32 v28, v28, v173, v181
v_max3_f32 v28, v28, v189, v197
v_max_f32 v28, v28, v205
v_sub_f32 v208, v149, v28
v_sub_f32 v209, v157, v28
v_sub_f32 v210, v165, v28
v_sub_f32 v211, v173, v28
v_sub_f32 v212, v181, v28
v_sub_f32 v213, v189, v28
v_sub_f32 v214, v197, v28
v_sub_f32 v215, v205, v28
v_exp_f32 v208, v208
v_exp_f32 v209, v209
v_exp_f32 v210, v210
v_exp_f32 v211, v211
v_exp_f32 v212, v212
v_exp_f32 v213, v213
v_exp_f32 v214, v214
v_exp_f32 v215, v215
s_nop 0
v_mul_f32 v29, v208, v150
v_fmac_f32 v29, v209, v158
v_fmac_f32 v29, v210, v166
v_fmac_f32 v29, v211, v174
v_fmac_f32 v29, v212, v182
v_fmac_f32 v29, v213, v190
v_fmac_f32 v29, v214, v198
v_fmac_f32 v29, v215, v206
v_rcp_f32 v29, v29
v_mul_f32 v216, v208, v144
v_mul_f32 v217, v208, v145
v_mul_f32 v218, v208, v146
v_mul_f32 v219, v208, v148
v_fmac_f32 v216, v209, v152
v_fmac_f32 v217, v209, v153
v_fmac_f32 v218, v209, v154
v_fmac_f32 v219, v209, v156
v_fmac_f32 v216, v210, v160
v_fmac_f32 v217, v210, v161
v_fmac_f32 v218, v210, v162
v_fmac_f32 v219, v210, v164
v_fmac_f32 v216, v211, v168
v_fmac_f32 v217, v211, v169
v_fmac_f32 v218, v211, v170
v_fmac_f32 v219, v211, v172
v_fmac_f32 v216, v212, v176
v_fmac_f32 v217, v212, v177
v_fmac_f32 v218, v212, v178
v_fmac_f32 v219, v212, v180
v_fmac_f32 v216, v213, v184
v_fmac_f32 v217, v213, v185
v_fmac_f32 v218, v213, v186
v_fmac_f32 v219, v213, v188
v_fmac_f32 v216, v214, v192
v_fmac_f32 v217, v214, v193
v_fmac_f32 v218, v214, v194
v_fmac_f32 v219, v214, v196
v_fmac_f32 v216, v215, v200
v_fmac_f32 v217, v215, v201
v_fmac_f32 v218, v215, v202
v_fmac_f32 v219, v215, v204
v_mul_f32 v216, v216, v29
v_mul_f32 v217, v217, v29
v_mul_f32 v218, v218, v29
v_mul_f32 v219, v219, v29
v_cvt_pk_bf16_f32 v28, v216, v216
v_and_b32 v240, v28, v20
v_and_b32 v241, v28, v21
v_and_b32 v242, v28, v22
v_and_b32 v243, v28, v23
v_cvt_pk_bf16_f32 v28, v217, v217
v_and_b32 v244, v28, v20
v_and_b32 v245, v28, v21
v_and_b32 v246, v28, v22
v_and_b32 v247, v28, v23
v_cvt_pk_bf16_f32 v28, v218, v218
v_and_b32 v248, v28, v20
v_and_b32 v249, v28, v21
v_and_b32 v250, v28, v22
v_and_b32 v251, v28, v23
v_cvt_pk_bf16_f32 v28, v219, v219
v_and_b32 v252, v28, v20
v_and_b32 v253, v28, v21
v_and_b32 v254, v28, v22
v_and_b32 v255, v28, v23
s_nop 1
v_mfma_f32_16x16x32_bf16 v[32:35], v[240:243], v[64:67], 0
v_mfma_f32_16x16x32_bf16 v[36:39], v[240:243], v[68:71], 0
v_mfma_f32_16x16x32_bf16 v[40:43], v[240:243], v[72:75], 0
v_mfma_f32_16x16x32_bf16 v[44:47], v[240:243], v[76:79], 0
v_mfma_f32_16x16x32_bf16 v[48:51], v[240:243], v[80:83], 0
v_mfma_f32_16x16x32_bf16 v[32:35], v[244:247], v[84:87], v[32:35]
v_mfma_f32_16x16x32_bf16 v[36:39], v[244:247], v[88:91], v[36:39]
v_mfma_f32_16x16x32_bf16 v[40:43], v[244:247], v[92:95], v[40:43]
v_mfma_f32_16x16x32_bf16 v[44:47], v[244:247], v[96:99], v[44:47]
v_mfma_f32_16x16x32_bf16 v[48:51], v[244:247], v[100:103], v[48:51]
v_mfma_f32_16x16x32_bf16 v[32:35], v[248:251], v[104:107], v[32:35]
v_mfma_f32_16x16x32_bf16 v[36:39], v[248:251], v[108:111], v[36:39]
v_mfma_f32_16x16x32_bf16 v[40:43], v[248:251], v[112:115], v[40:43]
v_mfma_f32_16x16x32_bf16 v[44:47], v[248:251], v[116:119], v[44:47]
v_mfma_f32_16x16x32_bf16 v[48:51], v[248:251], v[120:123], v[48:51]
v_mfma_f32_16x16x32_bf16 v[32:35], v[252:255], v[124:127], v[32:35]
v_mfma_f32_16x16x32_bf16 v[36:39], v[252:255], v[128:131], v[36:39]
v_mfma_f32_16x16x32_bf16 v[40:43], v[252:255], v[132:135], v[40:43]
v_mfma_f32_16x16x32_bf16 v[44:47], v[252:255], v[136:139], v[44:47]
v_mfma_f32_16x16x32_bf16 v[48:51], v[252:255], v[140:143], v[48:51]
s_nop 3
buffer_store_dwordx4 v[32:35], v15, s[40:43], s57 offen offset:0
buffer_store_dwordx4 v[36:39], v15, s[40:43], s57 offen offset:512
buffer_store_dwordx4 v[40:43], v15, s[40:43], s57 offen offset:1024
buffer_store_dwordx4 v[44:47], v15, s[40:43], s57 offen offset:1536
buffer_store_dwordx4 v[48:51], v15, s[40:43], s57 offen offset:2048
L_k1_end:
s_endpgm
.p2align 8
.type final_reduce_kernel,@function
final_reduce_kernel:
s_cmp_ge_u32 s2, 40
s_cbranch_scc1 L_k2_end
s_load_dwordx2 s[4:5], s[0:1], 40
s_load_dwordx2 s[6:7], s[0:1], 56
s_cmp_ge_u32 s2, 20
s_cselect_b32 s20, 1, 0
s_mul_i32 s21, s20, 20
s_sub_u32 s21, s2, s21
v_and_b32 v1, 7, v0
v_lshrrev_b32 v2, 3, v0
v_mul_u32_u24 v3, 40960, v2
v_lshl_add_u32 v3, v1, 4, v3
s_mul_i32 s22, s20, 2560
s_lshl_b32 s23, s21, 7
s_add_u32 s22, s22, s23
s_waitcnt lgkmcnt(0)
s_mov_b32 s8, s4
s_mov_b32 s9, s5
s_mov_b32 s10, 2560
s_mov_b32 s11, 0x00020000
s_mov_b32 s12, s6
s_mov_b32 s13, s7
s_mov_b32 s14, 1310720
s_mov_b32 s15, 0x00020000
buffer_load_dwordx4 v[32:35], v3, s[12:15], s22 offen
s_add_u32 s22, s22, 5120
buffer_load_dwordx4 v[36:39], v3, s[12:15], s22 offen
s_add_u32 s22, s22, 5120
buffer_load_dwordx4 v[40:43], v3, s[12:15], s22 offen
s_add_u32 s22, s22, 5120
buffer_load_dwordx4 v[44:47], v3, s[12:15], s22 offen
s_add_u32 s22, s22, 5120
buffer_load_dwordx4 v[48:51], v3, s[12:15], s22 offen
s_add_u32 s22, s22, 5120
buffer_load_dwordx4 v[52:55], v3, s[12:15], s22 offen
s_add_u32 s22, s22, 5120
buffer_load_dwordx4 v[56:59], v3, s[12:15], s22 offen
s_add_u32 s22, s22, 5120
buffer_load_dwordx4 v[60:63], v3, s[12:15], s22 offen
v_lshlrev_b32 v7, 4, v0
s_waitcnt vmcnt(0)
v_add_f32 v32, v32, v48
v_add_f32 v33, v33, v49
v_add_f32 v34, v34, v50
v_add_f32 v35, v35, v51
v_add_f32 v36, v36, v52
v_add_f32 v37, v37, v53
v_add_f32 v38, v38, v54
v_add_f32 v39, v39, v55
v_add_f32 v40, v40, v56
v_add_f32 v41, v41, v57
v_add_f32 v42, v42, v58
v_add_f32 v43, v43, v59
v_add_f32 v44, v44, v60
v_add_f32 v45, v45, v61
v_add_f32 v46, v46, v62
v_add_f32 v47, v47, v63
v_add_f32 v32, v32, v40
v_add_f32 v33, v33, v41
v_add_f32 v34, v34, v42
v_add_f32 v35, v35, v43
v_add_f32 v36, v36, v44
v_add_f32 v37, v37, v45
v_add_f32 v38, v38, v46
v_add_f32 v39, v39, v47
v_add_f32 v32, v32, v36
v_add_f32 v33, v33, v37
v_add_f32 v34, v34, v38
v_add_f32 v35, v35, v39
ds_write_b128 v7, v[32:35]
s_waitcnt lgkmcnt(0)
s_barrier
v_cmp_gt_u32 vcc, 32, v0
s_and_saveexec_b64 s[24:25], vcc
s_cbranch_execz L_k2_end
v_lshlrev_b32 v7, 2, v0
ds_read_b32 v16, v7 offset:0
ds_read_b32 v17, v7 offset:128
ds_read_b32 v18, v7 offset:256
ds_read_b32 v19, v7 offset:384
ds_read_b32 v20, v7 offset:512
ds_read_b32 v21, v7 offset:640
ds_read_b32 v22, v7 offset:768
ds_read_b32 v23, v7 offset:896
ds_read_b32 v24, v7 offset:1024
ds_read_b32 v25, v7 offset:1152
ds_read_b32 v26, v7 offset:1280
ds_read_b32 v27, v7 offset:1408
ds_read_b32 v28, v7 offset:1536
ds_read_b32 v29, v7 offset:1664
ds_read_b32 v30, v7 offset:1792
ds_read_b32 v31, v7 offset:1920
ds_read_b32 v32, v7 offset:2048
ds_read_b32 v33, v7 offset:2176
ds_read_b32 v34, v7 offset:2304
ds_read_b32 v35, v7 offset:2432
ds_read_b32 v36, v7 offset:2560
ds_read_b32 v37, v7 offset:2688
ds_read_b32 v38, v7 offset:2816
ds_read_b32 v39, v7 offset:2944
ds_read_b32 v40, v7 offset:3072
ds_read_b32 v41, v7 offset:3200
ds_read_b32 v42, v7 offset:3328
ds_read_b32 v43, v7 offset:3456
ds_read_b32 v44, v7 offset:3584
ds_read_b32 v45, v7 offset:3712
ds_read_b32 v46, v7 offset:3840
ds_read_b32 v47, v7 offset:3968
s_mul_i32 s26, s20, 1280
s_lshl_b32 s27, s21, 6
s_add_u32 s26, s26, s27
v_lshlrev_b32 v7, 1, v0
s_waitcnt lgkmcnt(0)
v_add_f32 v16, v16, v32
v_add_f32 v17, v17, v33
v_add_f32 v18, v18, v34
v_add_f32 v19, v19, v35
v_add_f32 v20, v20, v36
v_add_f32 v21, v21, v37
v_add_f32 v22, v22, v38
v_add_f32 v23, v23, v39
v_add_f32 v24, v24, v40
v_add_f32 v25, v25, v41
v_add_f32 v26, v26, v42
v_add_f32 v27, v27, v43
v_add_f32 v28, v28, v44
v_add_f32 v29, v29, v45
v_add_f32 v30, v30, v46
v_add_f32 v31, v31, v47
v_add_f32 v16, v16, v24
v_add_f32 v17, v17, v25
v_add_f32 v18, v18, v26
v_add_f32 v19, v19, v27
v_add_f32 v20, v20, v28
v_add_f32 v21, v21, v29
v_add_f32 v22, v22, v30
v_add_f32 v23, v23, v31
v_add_f32 v16, v16, v20
v_add_f32 v17, v17, v21
v_add_f32 v18, v18, v22
v_add_f32 v19, v19, v23
v_add_f32 v16, v16, v18
v_add_f32 v17, v17, v19
v_add_f32 v16, v16, v17
v_cvt_pk_bf16_f32 v16, v16, v16
buffer_store_short v16, v7, s[8:11], s26 offen
L_k2_end:
s_endpgm
.section .rodata,"a"
.p2align 6
.amdhsa_kernel standalone__sliding_block_cached__decode_kernel
  .amdhsa_next_free_vgpr 256
  .amdhsa_next_free_sgpr 100
  .amdhsa_accum_offset 256
  .amdhsa_group_segment_fixed_size 0
  .amdhsa_kernarg_size 64
  .amdhsa_user_sgpr_count 2
  .amdhsa_user_sgpr_kernarg_segment_ptr 1
  .amdhsa_system_sgpr_workgroup_id_x 1
.end_amdhsa_kernel

.p2align 6
.amdhsa_kernel final_reduce_kernel
  .amdhsa_next_free_vgpr 72
  .amdhsa_next_free_sgpr 40
  .amdhsa_accum_offset 72
  .amdhsa_group_segment_fixed_size 0
  .amdhsa_kernarg_size 64
  .amdhsa_user_sgpr_count 2
  .amdhsa_user_sgpr_kernarg_segment_ptr 1
  .amdhsa_system_sgpr_workgroup_id_x 1
.end_amdhsa_kernel
```
